```python
import torch

def _softmax(x, axis=-1):
    return torch.softmax(x, dim=axis)
def _gelu(x):
    return torch.nn.functional.gelu(x, approximate="tanh")
def _silu(x):
    return torch.nn.functional.silu(x)
def _sigmoid(x):
    return torch.sigmoid(x)
def _layernorm(x, axis=-1, eps=1e-5):
    m = x.mean(dim=axis, keepdim=True)
    v = x.var(dim=axis, keepdim=True, unbiased=False)
    return (x - m) / torch.sqrt(v + eps)
def _scatter_add(tgt, idx, src, axis=0):
    return tgt.clone().index_add_(axis, idx, src)
def _segment_sum(src, seg, n):
    out = torch.zeros((n,) + src.shape[1:], dtype=src.dtype)
    return out.index_add_(0, seg, src)
def _pad(x, pw):
    flat = tuple(v for pair in reversed(pw) for v in pair)
    return torch.nn.functional.pad(x, flat)

kernel_name = 'standalone__depthwise_separable__vision'

def setup_inputs():

    _w = (lambda a: (lambda t: t.to(torch.bfloat16) if t.is_floating_point() else t)(torch.as_tensor(a)))
    H = W = 512
    C = 192
    k = 1
    return {
        "x": _w((lambda *s: torch.randn(*s, dtype=torch.bfloat16) * 0.05)(1, H, W, C)),
        "dw": _w((lambda *s: torch.randn(*s, dtype=torch.bfloat16) * 0.05)(k, k, C)),
        "pw": _w((lambda *s: torch.randn(*s, dtype=torch.bfloat16) * 0.05)(C, C)),
    }

def reference(x, dw, pw):
    B, H, W, C = x.shape
    k = dw.shape[0]
    pad = k // 2
    xp = _pad(x, ((0,0),(pad,pad),(pad,pad),(0,0)))
    out = torch.zeros_like(x)
    for i in range(k):
        for j in range(k):
            out = out + xp[:, i:i+H, j:j+W, :] * dw[i, j][None, None, None, :]
    return torch.einsum('bhwc,cd->bhwd', out, pw)
```

```asm
; @launch grid=(256,1,1) block=(256,1,1) lds=148480
.amdgcn_target "amdgcn-amd-amdhsa--gfx950"
.text
.globl standalone__depthwise_separable__vision_kernel
.p2align 8
.type standalone__depthwise_separable__vision_kernel,@function
standalone__depthwise_separable__vision_kernel:
s_cmp_ge_u32 s2, 256
s_cbranch_scc1 L_end
s_load_dwordx4 s[4:7], s[0:1], 0
s_load_dwordx4 s[8:11], s[0:1], 16
s_load_dwordx4 s[36:39], s[0:1], 32
s_getpc_b64 s[90:91]
v_lshlrev_b32 v1, 7, v0
v_min_u32 v1, 9932, v1
v_mov_b32 v3, s91
v_add_co_u32 v2, vcc, s90, v1
s_nop 1
v_addc_co_u32 v3, vcc, 0, v3, vcc
v_cmp_gt_u32 vcc, 78, v0
s_and_saveexec_b64 s[88:89], vcc
s_cbranch_execz L_nowarm
global_load_dword v180, v[2:3], off
L_nowarm:
s_mov_b64 exec, s[88:89]
v_lshrrev_b32 v4, 6, v0
v_and_b32 v0, 63, v0
v_readfirstlane_b32 s3, v4
v_and_b32 v5, 15, v0
v_lshrrev_b32 v6, 4, v0
v_lshrrev_b32 v4, 3, v0
v_and_b32 v7, 6, v4
v_and_b32 v164, 7, v0
v_xor_b32 v164, v164, v7
v_lshlrev_b32 v164, 4, v164
v_lshl_add_u32 v164, v4, 7, v164
v_lshlrev_b32 v170, 4, v0
v_mul_u32_u24 v7, 3072, v6
v_lshl_add_u32 v172, v5, 4, v7
v_lshrrev_b32 v4, 3, v5
v_mul_u32_u24 v173, 384, v4
v_and_b32 v1, 7, v5
v_lshl_add_u32 v173, v1, 4, v173
v_add3_u32 v173, v173, v7, 64
v_add_u32 v173, 192, v173
v_lshl_add_u32 v175, v1, 1, v4
v_lshl_add_u32 v175, v6, 4, v175
v_lshlrev_b32 v175, 4, v175
s_lshl_b32 s12, s2, 2
s_add_u32 s12, s12, s3
s_mul_i32 s72, s12, 6144
s_mul_i32 s13, s3, 6144
s_add_u32 s13, s13, 73728
s_mov_b32 s18, 100663296
s_mov_b32 s19, 0x20000
s_mov_b32 s26, 73728
s_mov_b32 s27, 0x20000
s_mov_b32 s30, 384
s_mov_b32 s31, 0x20000
s_cmp_eq_u32 s3, 3
s_waitcnt lgkmcnt(0)
s_mov_b32 s24, s8
s_mov_b32 s16, s4
s_mov_b32 s28, s6
s_cbranch_scc1 L_prod
s_and_b32 s25, s9, 0xffff
s_add_u32 s32, s3, 0
s_lshr_b32 s33, s32, 1
s_and_b32 s34, s32, 1
s_mul_i32 s33, s33, 12288
s_mul_i32 s35, s34, 1536
s_add_u32 s40, s33, s35
s_lshl_b32 s35, s34, 3
s_add_u32 s80, s33, s35
buffer_load_dwordx4 v[8:11], v172, s[24:27], s40 offen offset:0
buffer_load_dwordx4 v[12:15], v172, s[24:27], s40 offen offset:384
buffer_load_dwordx4 v[16:19], v172, s[24:27], s40 offen offset:768
buffer_load_dwordx4 v[20:23], v172, s[24:27], s40 offen offset:1152
buffer_load_dwordx4 v[24:27], v173, s[24:27], s40 offen offset:0
buffer_load_dwordx4 v[28:31], v173, s[24:27], s40 offen offset:768
s_add_u32 s32, s3, 3
s_lshr_b32 s33, s32, 1
s_and_b32 s34, s32, 1
s_mul_i32 s33, s33, 12288
s_mul_i32 s35, s34, 1536
s_add_u32 s41, s33, s35
s_lshl_b32 s35, s34, 3
s_add_u32 s81, s33, s35
buffer_load_dwordx4 v[32:35], v172, s[24:27], s41 offen offset:0
buffer_load_dwordx4 v[36:39], v172, s[24:27], s41 offen offset:384
buffer_load_dwordx4 v[40:43], v172, s[24:27], s41 offen offset:768
buffer_load_dwordx4 v[44:47], v172, s[24:27], s41 offen offset:1152
buffer_load_dwordx4 v[48:51], v173, s[24:27], s41 offen offset:0
buffer_load_dwordx4 v[52:55], v173, s[24:27], s41 offen offset:768
s_add_u32 s32, s3, 6
s_lshr_b32 s33, s32, 1
s_and_b32 s34, s32, 1
s_mul_i32 s33, s33, 12288
s_mul_i32 s35, s34, 1536
s_add_u32 s42, s33, s35
s_lshl_b32 s35, s34, 3
s_add_u32 s82, s33, s35
buffer_load_dwordx4 v[56:59], v172, s[24:27], s42 offen offset:0
buffer_load_dwordx4 v[60:63], v172, s[24:27], s42 offen offset:384
buffer_load_dwordx4 v[64:67], v172, s[24:27], s42 offen offset:768
buffer_load_dwordx4 v[68:71], v172, s[24:27], s42 offen offset:1152
buffer_load_dwordx4 v[72:75], v173, s[24:27], s42 offen offset:0
buffer_load_dwordx4 v[76:79], v173, s[24:27], s42 offen offset:768
s_add_u32 s32, s3, 9
s_lshr_b32 s33, s32, 1
s_and_b32 s34, s32, 1
s_mul_i32 s33, s33, 12288
s_mul_i32 s35, s34, 1536
s_add_u32 s43, s33, s35
s_lshl_b32 s35, s34, 3
s_add_u32 s83, s33, s35
buffer_load_dwordx4 v[80:83], v172, s[24:27], s43 offen offset:0
buffer_load_dwordx4 v[84:87], v172, s[24:27], s43 offen offset:384
buffer_load_dwordx4 v[88:91], v172, s[24:27], s43 offen offset:768
buffer_load_dwordx4 v[92:95], v172, s[24:27], s43 offen offset:1152
buffer_load_dwordx4 v[96:99], v173, s[24:27], s43 offen offset:0
buffer_load_dwordx4 v[100:103], v173, s[24:27], s43 offen offset:768
s_and_b32 s17, s5, 0xffff
s_branch L_common1
L_prod:
s_and_b32 s17, s5, 0xffff
s_and_b32 s29, s7, 0xffff
s_mov_b32 s32, 73728
s_sub_u32 s33, s72, 18432
s_mov_b32 m0, s32
s_add_u32 s55, s33, 4096
buffer_load_dwordx4 v164, s[16:19], s33 offen offset:0 nt lds
buffer_load_dwordx4 v164, s[16:19], s33 offen offset:1024 nt lds
buffer_load_dwordx4 v164, s[16:19], s33 offen offset:2048 nt lds
buffer_load_dwordx4 v164, s[16:19], s33 offen offset:3072 nt lds
s_add_u32 m0, s32, 4096
s_nop 0
buffer_load_dwordx4 v164, s[16:19], s55 offen offset:0 nt lds
buffer_load_dwordx4 v164, s[16:19], s55 offen offset:1024 nt lds
s_mov_b32 m0, 147456
s_nop 0
buffer_load_dwordx4 v170, s[28:31], 0 offen lds
s_mov_b32 s32, 79872
s_sub_u32 s33, s72, 12288
s_mov_b32 m0, s32
s_add_u32 s55, s33, 4096
buffer_load_dwordx4 v164, s[16:19], s33 offen offset:0 nt lds
buffer_load_dwordx4 v164, s[16:19], s33 offen offset:1024 nt lds
buffer_load_dwordx4 v164, s[16:19], s33 offen offset:2048 nt lds
buffer_load_dwordx4 v164, s[16:19], s33 offen offset:3072 nt lds
s_add_u32 m0, s32, 4096
s_nop 0
buffer_load_dwordx4 v164, s[16:19], s55 offen offset:0 nt lds
buffer_load_dwordx4 v164, s[16:19], s55 offen offset:1024 nt lds
s_mov_b32 s32, 86016
s_sub_u32 s33, s72, 6144
s_mov_b32 m0, s32
s_add_u32 s55, s33, 4096
buffer_load_dwordx4 v164, s[16:19], s33 offen offset:0 nt lds
buffer_load_dwordx4 v164, s[16:19], s33 offen offset:1024 nt lds
buffer_load_dwordx4 v164, s[16:19], s33 offen offset:2048 nt lds
buffer_load_dwordx4 v164, s[16:19], s33 offen offset:3072 nt lds
s_add_u32 m0, s32, 4096
s_nop 0
buffer_load_dwordx4 v164, s[16:19], s55 offen offset:0 nt lds
buffer_load_dwordx4 v164, s[16:19], s55 offen offset:1024 nt lds
s_mov_b32 s32, 92160
s_sub_u32 s33, s72, 0
s_mov_b32 m0, s32
s_add_u32 s55, s33, 4096
buffer_load_dwordx4 v164, s[16:19], s33 offen offset:0 nt lds
buffer_load_dwordx4 v164, s[16:19], s33 offen offset:1024 nt lds
buffer_load_dwordx4 v164, s[16:19], s33 offen offset:2048 nt lds
buffer_load_dwordx4 v164, s[16:19], s33 offen offset:3072 nt lds
s_add_u32 m0, s32, 4096
s_nop 0
buffer_load_dwordx4 v164, s[16:19], s55 offen offset:0 nt lds
buffer_load_dwordx4 v164, s[16:19], s55 offen offset:1024 nt lds
L_common1:
v_mul_u32_u24 v7, 1536, v6
v_lshl_add_u32 v2, v5, 4, v7
v_lshl_add_u32 v3, v5, 3, v7
v_add_u32 v3, 256, v3
v_mul_u32_u24 v4, 3, v5
v_add_u32 v7, 0, v4
v_and_b32 v158, 6, v7
v_add_u32 v159, 0, v6
v_xor_b32 v158, v158, v159
v_lshlrev_b32 v158, 4, v158
v_lshl_add_u32 v152, v7, 7, v158
v_add_u32 v7, 0, v4
v_and_b32 v158, 6, v7
v_add_u32 v159, 4, v6
v_xor_b32 v158, v158, v159
v_lshlrev_b32 v158, 4, v158
v_lshl_add_u32 v153, v7, 7, v158
v_add_u32 v7, 1, v4
v_and_b32 v158, 6, v7
v_add_u32 v159, 0, v6
v_xor_b32 v158, v158, v159
v_lshlrev_b32 v158, 4, v158
v_lshl_add_u32 v154, v7, 7, v158
v_add_u32 v7, 1, v4
v_and_b32 v158, 6, v7
v_add_u32 v159, 4, v6
v_xor_b32 v158, v158, v159
v_lshlrev_b32 v158, 4, v158
v_lshl_add_u32 v155, v7, 7, v158
v_add_u32 v7, 2, v4
v_and_b32 v158, 6, v7
v_add_u32 v159, 0, v6
v_xor_b32 v158, v158, v159
v_lshlrev_b32 v158, 4, v158
v_lshl_add_u32 v156, v7, 7, v158
v_add_u32 v7, 2, v4
v_and_b32 v158, 6, v7
v_add_u32 v159, 4, v6
v_xor_b32 v158, v158, v159
v_lshlrev_b32 v158, 4, v158
v_lshl_add_u32 v157, v7, 7, v158
v_lshlrev_b32 v176, 4, v6
v_add_u32 v176, 147456, v176
v_add_u32 v171, 0x10000, v170
s_mov_b32 s20, s10
s_and_b32 s21, s11, 0xffff
s_mov_b32 s22, 100663296
s_mov_b32 s23, 0x20000
s_mov_b32 s60, 0x05040100
s_mov_b32 s61, 0x07060302
s_lshr_b32 s49, s2, 4
s_mul_i32 s50, s49, 4096
s_lshl_b32 s51, s49, 2
s_add_u32 s52, s49, 12288
s_mul_i32 s52, s52, 6144
s_and_b32 s53, s12, 63
s_cmp_eq_u32 s53, 0
s_cselect_b32 s53, 1, 0
s_mov_b32 s44, s36
s_and_b32 s45, s37, 0xffff
s_mov_b32 s46, 256
s_mov_b32 s47, 0x20000
s_mov_b32 s56, s38
s_and_b32 s57, s39, 0xffff
s_mov_b32 s58, 65536
s_mov_b32 s59, 0x20000
s_add_u32 s14, s13, 24576
s_mov_b32 s15, s13
s_add_u32 s77, s13, 73728
s_add_u32 s76, s72, 6291456
s_mul_i32 s79, s3, 1
s_add_u32 s79, s79, 4
s_cmp_eq_u32 s3, 3
s_cbranch_scc1 L_prod2
s_cmp_eq_u32 s53, 0
s_cbranch_scc1 L_np1
v_mov_b32 v166, 1
v_mov_b32 v167, 0
s_mov_b64 exec, 1
buffer_atomic_cmpswap v[166:167], off, s[44:47], s51 sc0 sc1
s_mov_b64 exec, -1
L_np1:
s_waitcnt vmcnt(18)
v_mov_b32 v178, v24
v_mov_b32 v179, v25
v_mov_b32_dpp v24, v26 row_ror:8 row_mask:0xf bank_mask:0xc
v_mov_b32_dpp v25, v27 row_ror:8 row_mask:0xf bank_mask:0xc
v_mov_b32_dpp v26, v178 row_ror:8 row_mask:0xf bank_mask:0x3
v_mov_b32_dpp v27, v179 row_ror:8 row_mask:0xf bank_mask:0x3
v_mov_b32 v178, v28
v_mov_b32 v179, v29
v_mov_b32_dpp v28, v30 row_ror:8 row_mask:0xf bank_mask:0xc
v_mov_b32_dpp v29, v31 row_ror:8 row_mask:0xf bank_mask:0xc
v_mov_b32_dpp v30, v178 row_ror:8 row_mask:0xf bank_mask:0x3
v_mov_b32_dpp v31, v179 row_ror:8 row_mask:0xf bank_mask:0x3
v_perm_b32 v224, v12, v8, s60
v_perm_b32 v225, v20, v16, s60
v_perm_b32 v226, v12, v8, s61
v_perm_b32 v227, v20, v16, s61
v_perm_b32 v228, v13, v9, s60
v_perm_b32 v229, v21, v17, s60
v_perm_b32 v230, v13, v9, s61
v_perm_b32 v231, v21, v17, s61
v_perm_b32 v232, v14, v10, s60
v_perm_b32 v233, v22, v18, s60
v_perm_b32 v234, v14, v10, s61
v_perm_b32 v235, v22, v18, s61
v_perm_b32 v236, v15, v11, s60
v_perm_b32 v237, v23, v19, s60
v_perm_b32 v238, v15, v11, s61
v_perm_b32 v239, v23, v19, s61
v_perm_b32 v240, v26, v24, s60
v_perm_b32 v241, v30, v28, s60
v_perm_b32 v242, v26, v24, s61
v_perm_b32 v243, v30, v28, s61
v_perm_b32 v244, v27, v25, s60
v_perm_b32 v245, v31, v29, s60
v_perm_b32 v246, v27, v25, s61
v_perm_b32 v247, v31, v29, s61
v_add_u32 v174, s80, v170
v_add_u32 v1, s80, v175
ds_write_b64 v174, v[224:225] offset:0
ds_write_b64 v174, v[226:227] offset:1024
ds_write_b64 v174, v[228:229] offset:2048
ds_write_b64 v174, v[230:231] offset:3072
ds_write_b64 v174, v[232:233] offset:4096
ds_write_b64 v174, v[234:235] offset:5120
ds_write_b64 v174, v[236:237] offset:6144
ds_write_b64 v174, v[238:239] offset:7168
ds_write_b64 v1, v[240:241] offset:8192
ds_write_b64 v1, v[242:243] offset:9216
ds_write_b64 v1, v[244:245] offset:10240
ds_write_b64 v1, v[246:247] offset:11264
s_waitcnt vmcnt(12)
v_mov_b32 v178, v48
v_mov_b32 v179, v49
v_mov_b32_dpp v48, v50 row_ror:8 row_mask:0xf bank_mask:0xc
v_mov_b32_dpp v49, v51 row_ror:8 row_mask:0xf bank_mask:0xc
v_mov_b32_dpp v50, v178 row_ror:8 row_mask:0xf bank_mask:0x3
v_mov_b32_dpp v51, v179 row_ror:8 row_mask:0xf bank_mask:0x3
v_mov_b32 v178, v52
v_mov_b32 v179, v53
v_mov_b32_dpp v52, v54 row_ror:8 row_mask:0xf bank_mask:0xc
v_mov_b32_dpp v53, v55 row_ror:8 row_mask:0xf bank_mask:0xc
v_mov_b32_dpp v54, v178 row_ror:8 row_mask:0xf bank_mask:0x3
v_mov_b32_dpp v55, v179 row_ror:8 row_mask:0xf bank_mask:0x3
v_perm_b32 v200, v36, v32, s60
v_perm_b32 v201, v44, v40, s60
v_perm_b32 v202, v36, v32, s61
v_perm_b32 v203, v44, v40, s61
v_perm_b32 v204, v37, v33, s60
v_perm_b32 v205, v45, v41, s60
v_perm_b32 v206, v37, v33, s61
v_perm_b32 v207, v45, v41, s61
v_perm_b32 v208, v38, v34, s60
v_perm_b32 v209, v46, v42, s60
v_perm_b32 v210, v38, v34, s61
v_perm_b32 v211, v46, v42, s61
v_perm_b32 v212, v39, v35, s60
v_perm_b32 v213, v47, v43, s60
v_perm_b32 v214, v39, v35, s61
v_perm_b32 v215, v47, v43, s61
v_perm_b32 v216, v50, v48, s60
v_perm_b32 v217, v54, v52, s60
v_perm_b32 v218, v50, v48, s61
v_perm_b32 v219, v54, v52, s61
v_perm_b32 v220, v51, v49, s60
v_perm_b32 v221, v55, v53, s60
v_perm_b32 v222, v51, v49, s61
v_perm_b32 v223, v55, v53, s61
v_add_u32 v174, s81, v170
v_add_u32 v1, s81, v175
ds_write_b64 v174, v[200:201] offset:0
ds_write_b64 v174, v[202:203] offset:1024
ds_write_b64 v174, v[204:205] offset:2048
ds_write_b64 v174, v[206:207] offset:3072
ds_write_b64 v174, v[208:209] offset:4096
ds_write_b64 v174, v[210:211] offset:5120
ds_write_b64 v174, v[212:213] offset:6144
ds_write_b64 v174, v[214:215] offset:7168
ds_write_b64 v1, v[216:217] offset:8192
ds_write_b64 v1, v[218:219] offset:9216
ds_write_b64 v1, v[220:221] offset:10240
ds_write_b64 v1, v[222:223] offset:11264
s_waitcnt vmcnt(6)
s_waitcnt lgkmcnt(12)
v_mov_b32 v178, v72
v_mov_b32 v179, v73
v_mov_b32_dpp v72, v74 row_ror:8 row_mask:0xf bank_mask:0xc
v_mov_b32_dpp v73, v75 row_ror:8 row_mask:0xf bank_mask:0xc
v_mov_b32_dpp v74, v178 row_ror:8 row_mask:0xf bank_mask:0x3
v_mov_b32_dpp v75, v179 row_ror:8 row_mask:0xf bank_mask:0x3
v_mov_b32 v178, v76
v_mov_b32 v179, v77
v_mov_b32_dpp v76, v78 row_ror:8 row_mask:0xf bank_mask:0xc
v_mov_b32_dpp v77, v79 row_ror:8 row_mask:0xf bank_mask:0xc
v_mov_b32_dpp v78, v178 row_ror:8 row_mask:0xf bank_mask:0x3
v_mov_b32_dpp v79, v179 row_ror:8 row_mask:0xf bank_mask:0x3
v_perm_b32 v224, v60, v56, s60
v_perm_b32 v225, v68, v64, s60
v_perm_b32 v226, v60, v56, s61
v_perm_b32 v227, v68, v64, s61
v_perm_b32 v228, v61, v57, s60
v_perm_b32 v229, v69, v65, s60
v_perm_b32 v230, v61, v57, s61
v_perm_b32 v231, v69, v65, s61
v_perm_b32 v232, v62, v58, s60
v_perm_b32 v233, v70, v66, s60
v_perm_b32 v234, v62, v58, s61
v_perm_b32 v235, v70, v66, s61
v_perm_b32 v236, v63, v59, s60
v_perm_b32 v237, v71, v67, s60
v_perm_b32 v238, v63, v59, s61
v_perm_b32 v239, v71, v67, s61
v_perm_b32 v240, v74, v72, s60
v_perm_b32 v241, v78, v76, s60
v_perm_b32 v242, v74, v72, s61
v_perm_b32 v243, v78, v76, s61
v_perm_b32 v244, v75, v73, s60
v_perm_b32 v245, v79, v77, s60
v_perm_b32 v246, v75, v73, s61
v_perm_b32 v247, v79, v77, s61
v_add_u32 v174, s82, v170
v_add_u32 v1, s82, v175
ds_write_b64 v174, v[224:225] offset:0
ds_write_b64 v174, v[226:227] offset:1024
ds_write_b64 v174, v[228:229] offset:2048
ds_write_b64 v174, v[230:231] offset:3072
ds_write_b64 v174, v[232:233] offset:4096
ds_write_b64 v174, v[234:235] offset:5120
ds_write_b64 v174, v[236:237] offset:6144
ds_write_b64 v174, v[238:239] offset:7168
ds_write_b64 v1, v[240:241] offset:8192
ds_write_b64 v1, v[242:243] offset:9216
ds_write_b64 v1, v[244:245] offset:10240
ds_write_b64 v1, v[246:247] offset:11264
s_waitcnt vmcnt(0)
s_waitcnt lgkmcnt(12)
v_mov_b32 v178, v96
v_mov_b32 v179, v97
v_mov_b32_dpp v96, v98 row_ror:8 row_mask:0xf bank_mask:0xc
v_mov_b32_dpp v97, v99 row_ror:8 row_mask:0xf bank_mask:0xc
v_mov_b32_dpp v98, v178 row_ror:8 row_mask:0xf bank_mask:0x3
v_mov_b32_dpp v99, v179 row_ror:8 row_mask:0xf bank_mask:0x3
v_mov_b32 v178, v100
v_mov_b32 v179, v101
v_mov_b32_dpp v100, v102 row_ror:8 row_mask:0xf bank_mask:0xc
v_mov_b32_dpp v101, v103 row_ror:8 row_mask:0xf bank_mask:0xc
v_mov_b32_dpp v102, v178 row_ror:8 row_mask:0xf bank_mask:0x3
v_mov_b32_dpp v103, v179 row_ror:8 row_mask:0xf bank_mask:0x3
v_perm_b32 v200, v84, v80, s60
v_perm_b32 v201, v92, v88, s60
v_perm_b32 v202, v84, v80, s61
v_perm_b32 v203, v92, v88, s61
v_perm_b32 v204, v85, v81, s60
v_perm_b32 v205, v93, v89, s60
v_perm_b32 v206, v85, v81, s61
v_perm_b32 v207, v93, v89, s61
v_perm_b32 v208, v86, v82, s60
v_perm_b32 v209, v94, v90, s60
v_perm_b32 v210, v86, v82, s61
v_perm_b32 v211, v94, v90, s61
v_perm_b32 v212, v87, v83, s60
v_perm_b32 v213, v95, v91, s60
v_perm_b32 v214, v87, v83, s61
v_perm_b32 v215, v95, v91, s61
v_perm_b32 v216, v98, v96, s60
v_perm_b32 v217, v102, v100, s60
v_perm_b32 v218, v98, v96, s61
v_perm_b32 v219, v102, v100, s61
v_perm_b32 v220, v99, v97, s60
v_perm_b32 v221, v103, v101, s60
v_perm_b32 v222, v99, v97, s61
v_perm_b32 v223, v103, v101, s61
v_add_u32 v174, s83, v170
v_add_u32 v1, s83, v175
ds_write_b64 v174, v[200:201] offset:0
ds_write_b64 v174, v[202:203] offset:1024
ds_write_b64 v174, v[204:205] offset:2048
ds_write_b64 v174, v[206:207] offset:3072
ds_write_b64 v174, v[208:209] offset:4096
ds_write_b64 v174, v[210:211] offset:5120
ds_write_b64 v174, v[212:213] offset:6144
ds_write_b64 v174, v[214:215] offset:7168
ds_write_b64 v1, v[216:217] offset:8192
ds_write_b64 v1, v[218:219] offset:9216
ds_write_b64 v1, v[220:221] offset:10240
ds_write_b64 v1, v[222:223] offset:11264
s_mov_b32 m0, s14
s_add_u32 s55, s76, 4096
buffer_load_dwordx4 v164, s[16:19], s76 offen offset:0 nt lds
buffer_load_dwordx4 v164, s[16:19], s76 offen offset:1024 nt lds
buffer_load_dwordx4 v164, s[16:19], s76 offen offset:2048 nt lds
buffer_load_dwordx4 v164, s[16:19], s76 offen offset:3072 nt lds
s_add_u32 m0, s14, 4096
s_nop 0
buffer_load_dwordx4 v164, s[16:19], s55 offen offset:0 nt lds
buffer_load_dwordx4 v164, s[16:19], s55 offen offset:1024 nt lds
s_add_u32 s14, s14, 24576
s_cmp_ge_u32 s14, s77
s_cselect_b32 s14, s13, s14
s_add_u32 s76, s76, 6291456
s_waitcnt lgkmcnt(0)
s_barrier
s_mov_b32 m0, s14
s_add_u32 s55, s76, 4096
buffer_load_dwordx4 v164, s[16:19], s76 offen offset:0 nt lds
buffer_load_dwordx4 v164, s[16:19], s76 offen offset:1024 nt lds
buffer_load_dwordx4 v164, s[16:19], s76 offen offset:2048 nt lds
buffer_load_dwordx4 v164, s[16:19], s76 offen offset:3072 nt lds
s_add_u32 m0, s14, 4096
s_nop 0
buffer_load_dwordx4 v164, s[16:19], s55 offen offset:0 nt lds
buffer_load_dwordx4 v164, s[16:19], s55 offen offset:1024 nt lds
s_add_u32 s14, s14, 24576
s_cmp_ge_u32 s14, s77
s_cselect_b32 s14, s13, s14
s_add_u32 s76, s76, 6291456
s_branch L_go0
L_prod2:
s_mov_b32 m0, s14
s_add_u32 s55, s76, 4096
buffer_load_dwordx4 v164, s[16:19], s76 offen offset:0 nt lds
buffer_load_dwordx4 v164, s[16:19], s76 offen offset:1024 nt lds
buffer_load_dwordx4 v164, s[16:19], s76 offen offset:2048 nt lds
buffer_load_dwordx4 v164, s[16:19], s76 offen offset:3072 nt lds
s_add_u32 m0, s14, 4096
s_nop 0
buffer_load_dwordx4 v164, s[16:19], s55 offen offset:0 nt lds
buffer_load_dwordx4 v164, s[16:19], s55 offen offset:1024 nt lds
s_add_u32 s14, s14, 24576
s_cmp_ge_u32 s14, s77
s_cselect_b32 s14, s13, s14
s_add_u32 s76, s76, 6291456
s_mov_b32 m0, s14
s_add_u32 s55, s76, 4096
buffer_load_dwordx4 v164, s[16:19], s76 offen offset:0 nt lds
buffer_load_dwordx4 v164, s[16:19], s76 offen offset:1024 nt lds
buffer_load_dwordx4 v164, s[16:19], s76 offen offset:2048 nt lds
buffer_load_dwordx4 v164, s[16:19], s76 offen offset:3072 nt lds
s_add_u32 m0, s14, 4096
s_nop 0
buffer_load_dwordx4 v164, s[16:19], s55 offen offset:0 nt lds
buffer_load_dwordx4 v164, s[16:19], s55 offen offset:1024 nt lds
s_add_u32 s14, s14, 24576
s_cmp_ge_u32 s14, s77
s_cselect_b32 s14, s13, s14
s_add_u32 s76, s76, 6291456
s_waitcnt vmcnt(12)
s_bitcmp1_b32 s2, 3
s_cbranch_scc0 L_cl0
s_waitcnt vmcnt(0)
L_cl0:
s_barrier
L_go0:
ds_read_b128 v[32:35], v176 offset:0
ds_read_b128 v[36:39], v176 offset:64
ds_read_b128 v[40:43], v176 offset:128
ds_read_b128 v[44:47], v176 offset:192
ds_read_b128 v[48:51], v176 offset:256
ds_read_b128 v[52:55], v176 offset:320
v_add_u32 v158, s15, v152
v_add_u32 v159, s15, v153
v_add_u32 v160, s15, v154
v_add_u32 v161, s15, v155
v_add_u32 v162, s15, v156
v_add_u32 v163, s15, v157
ds_read_b128 v[128:131], v158
ds_read_b128 v[132:135], v159
ds_read_b128 v[136:139], v160
ds_read_b128 v[140:143], v161
ds_read_b128 v[144:147], v162
ds_read_b128 v[148:151], v163
s_add_u32 s15, s15, 24576
s_waitcnt lgkmcnt(6)
ds_read_b128 a[0:3], v170 offset:0
ds_read_b128 a[4:7], v170 offset:1024
ds_read_b128 a[8:11], v170 offset:2048
ds_read_b128 a[12:15], v170 offset:3072
ds_read_b128 a[16:19], v170 offset:4096
ds_read_b128 a[20:23], v170 offset:5120
ds_read_b128 a[24:27], v170 offset:6144
ds_read_b128 a[28:31], v170 offset:7168
ds_read_b128 a[32:35], v170 offset:8192
ds_read_b128 a[36:39], v170 offset:9216
ds_read_b128 a[40:43], v170 offset:10240
ds_read_b128 a[44:47], v170 offset:11264
v_lshlrev_b32 v8, 16, v32
v_and_b32 v9, 0xffff0000, v32
v_lshlrev_b32 v10, 16, v33
v_and_b32 v11, 0xffff0000, v33
v_lshlrev_b32 v12, 16, v34
v_and_b32 v13, 0xffff0000, v34
v_lshlrev_b32 v14, 16, v35
v_and_b32 v15, 0xffff0000, v35
v_lshlrev_b32 v16, 16, v36
v_and_b32 v17, 0xffff0000, v36
v_lshlrev_b32 v18, 16, v37
v_and_b32 v19, 0xffff0000, v37
v_lshlrev_b32 v20, 16, v38
v_and_b32 v21, 0xffff0000, v38
v_lshlrev_b32 v22, 16, v39
v_and_b32 v23, 0xffff0000, v39
v_lshlrev_b32 v24, 16, v40
v_and_b32 v25, 0xffff0000, v40
v_lshlrev_b32 v26, 16, v41
v_and_b32 v27, 0xffff0000, v41
v_lshlrev_b32 v28, 16, v42
v_and_b32 v29, 0xffff0000, v42
v_lshlrev_b32 v30, 16, v43
v_and_b32 v31, 0xffff0000, v43
v_lshlrev_b32 v32, 16, v44
v_and_b32 v33, 0xffff0000, v44
v_lshlrev_b32 v34, 16, v45
v_and_b32 v35, 0xffff0000, v45
v_lshlrev_b32 v36, 16, v46
v_and_b32 v37, 0xffff0000, v46
v_lshlrev_b32 v38, 16, v47
v_and_b32 v39, 0xffff0000, v47
v_lshlrev_b32 v40, 16, v48
v_and_b32 v41, 0xffff0000, v48
v_lshlrev_b32 v42, 16, v49
v_and_b32 v43, 0xffff0000, v49
v_lshlrev_b32 v44, 16, v50
v_and_b32 v45, 0xffff0000, v50
v_lshlrev_b32 v46, 16, v51
v_and_b32 v47, 0xffff0000, v51
v_lshlrev_b32 v48, 16, v52
v_and_b32 v49, 0xffff0000, v52
v_lshlrev_b32 v50, 16, v53
v_and_b32 v51, 0xffff0000, v53
v_lshlrev_b32 v52, 16, v54
v_and_b32 v53, 0xffff0000, v54
v_lshlrev_b32 v54, 16, v55
v_and_b32 v55, 0xffff0000, v55
s_waitcnt lgkmcnt(6)
ds_read_b128 a[48:51], v170 offset:12288
ds_read_b128 a[52:55], v170 offset:13312
ds_read_b128 a[56:59], v170 offset:14336
ds_read_b128 a[60:63], v170 offset:15360
ds_read_b128 a[64:67], v170 offset:16384
ds_read_b128 a[68:71], v170 offset:17408
ds_read_b128 a[72:75], v170 offset:18432
ds_read_b128 a[76:79], v170 offset:19456
ds_read_b128 a[80:83], v170 offset:20480
ds_read_b128 a[84:87], v170 offset:21504
ds_read_b128 a[88:91], v170 offset:22528
ds_read_b128 a[92:95], v170 offset:23552
s_waitcnt lgkmcnt(6)
ds_read_b128 a[96:99], v170 offset:24576
ds_read_b128 a[100:103], v170 offset:25600
ds_read_b128 a[104:107], v170 offset:26624
ds_read_b128 a[108:111], v170 offset:27648
ds_read_b128 a[112:115], v170 offset:28672
ds_read_b128 a[116:119], v170 offset:29696
ds_read_b128 a[120:123], v170 offset:30720
ds_read_b128 a[124:127], v170 offset:31744
ds_read_b128 a[128:131], v170 offset:32768
ds_read_b128 a[132:135], v170 offset:33792
ds_read_b128 a[136:139], v170 offset:34816
ds_read_b128 a[140:143], v170 offset:35840
s_waitcnt lgkmcnt(6)
ds_read_b128 a[144:147], v170 offset:36864
ds_read_b128 a[148:151], v170 offset:37888
ds_read_b128 a[152:155], v170 offset:38912
ds_read_b128 a[156:159], v170 offset:39936
ds_read_b128 a[160:163], v170 offset:40960
ds_read_b128 a[164:167], v170 offset:41984
ds_read_b128 a[168:171], v170 offset:43008
ds_read_b128 a[172:175], v170 offset:44032
ds_read_b128 a[176:179], v170 offset:45056
ds_read_b128 a[180:183], v170 offset:46080
ds_read_b128 a[184:187], v170 offset:47104
ds_read_b128 a[188:191], v170 offset:48128
s_waitcnt lgkmcnt(6)
ds_read_b128 a[192:195], v170 offset:49152
ds_read_b128 a[196:199], v170 offset:50176
ds_read_b128 a[200:203], v170 offset:51200
ds_read_b128 a[204:207], v170 offset:52224
ds_read_b128 a[208:211], v170 offset:53248
ds_read_b128 a[212:215], v170 offset:54272
ds_read_b128 a[216:219], v170 offset:55296
ds_read_b128 a[220:223], v170 offset:56320
ds_read_b128 a[224:227], v170 offset:57344
ds_read_b128 a[228:231], v170 offset:58368
ds_read_b128 a[232:235], v170 offset:59392
ds_read_b128 a[236:239], v170 offset:60416
s_waitcnt lgkmcnt(6)
ds_read_b128 a[240:243], v170 offset:61440
ds_read_b128 a[244:247], v170 offset:62464
ds_read_b128 a[248:251], v170 offset:63488
ds_read_b128 a[252:255], v170 offset:64512
ds_read_b128 v[224:227], v171 offset:0
ds_read_b128 v[228:231], v171 offset:1024
ds_read_b128 v[232:235], v171 offset:2048
ds_read_b128 v[236:239], v171 offset:3072
ds_read_b128 v[240:243], v171 offset:4096
ds_read_b128 v[244:247], v171 offset:5120
ds_read_b128 v[248:251], v171 offset:6144
ds_read_b128 v[252:255], v171 offset:7168
s_waitcnt lgkmcnt(12)
v_lshlrev_b32 v4, 16, v128
v_and_b32 v5, 0xffff0000, v128
v_mul_f32 v4, v4, v8
v_mul_f32 v5, v5, v9
v_cvt_pk_bf16_f32 v128, v4, v5
v_lshlrev_b32 v6, 16, v129
v_and_b32 v7, 0xffff0000, v129
v_mul_f32 v6, v6, v10
v_mul_f32 v7, v7, v11
v_cvt_pk_bf16_f32 v129, v6, v7
v_lshlrev_b32 v4, 16, v130
v_and_b32 v5, 0xffff0000, v130
v_mul_f32 v4, v4, v12
v_mul_f32 v5, v5, v13
v_cvt_pk_bf16_f32 v130, v4, v5
v_lshlrev_b32 v6, 16, v131
v_and_b32 v7, 0xffff0000, v131
v_mul_f32 v6, v6, v14
v_mul_f32 v7, v7, v15
v_cvt_pk_bf16_f32 v131, v6, v7
s_waitcnt lgkmcnt(0)
s_nop 1
v_mfma_f32_16x16x32_bf16 v[56:59], v[128:131], a[0:3], 0
v_lshlrev_b32 v4, 16, v132
v_and_b32 v5, 0xffff0000, v132
v_mfma_f32_16x16x32_bf16 v[60:63], v[128:131], a[4:7], 0
v_mul_f32 v4, v4, v16
v_mul_f32 v5, v5, v17
v_mfma_f32_16x16x32_bf16 v[64:67], v[128:131], a[8:11], 0
v_cvt_pk_bf16_f32 v132, v4, v5
v_lshlrev_b32 v6, 16, v133
v_mfma_f32_16x16x32_bf16 v[68:71], v[128:131], a[12:15], 0
v_and_b32 v7, 0xffff0000, v133
v_mul_f32 v6, v6, v18
v_mfma_f32_16x16x32_bf16 v[72:75], v[128:131], a[16:19], 0
v_mul_f32 v7, v7, v19
v_cvt_pk_bf16_f32 v133, v6, v7
v_mfma_f32_16x16x32_bf16 v[76:79], v[128:131], a[20:23], 0
v_lshlrev_b32 v4, 16, v134
v_and_b32 v5, 0xffff0000, v134
v_mfma_f32_16x16x32_bf16 v[80:83], v[128:131], a[24:27], 0
v_mul_f32 v4, v4, v20
v_mul_f32 v5, v5, v21
v_mfma_f32_16x16x32_bf16 v[84:87], v[128:131], a[28:31], 0
v_cvt_pk_bf16_f32 v134, v4, v5
v_lshlrev_b32 v6, 16, v135
v_mfma_f32_16x16x32_bf16 v[88:91], v[128:131], a[32:35], 0
v_and_b32 v7, 0xffff0000, v135
v_mul_f32 v6, v6, v22
v_mfma_f32_16x16x32_bf16 v[92:95], v[128:131], a[36:39], 0
v_mul_f32 v7, v7, v23
v_cvt_pk_bf16_f32 v135, v6, v7
v_mfma_f32_16x16x32_bf16 v[96:99], v[128:131], a[40:43], 0
v_mfma_f32_16x16x32_bf16 v[100:103], v[128:131], a[44:47], 0
v_mfma_f32_16x16x32_bf16 v[56:59], v[132:135], a[48:51], v[56:59]
v_lshlrev_b32 v4, 16, v136
v_and_b32 v5, 0xffff0000, v136
v_mfma_f32_16x16x32_bf16 v[60:63], v[132:135], a[52:55], v[60:63]
v_mul_f32 v4, v4, v24
v_mul_f32 v5, v5, v25
v_mfma_f32_16x16x32_bf16 v[64:67], v[132:135], a[56:59], v[64:67]
v_cvt_pk_bf16_f32 v136, v4, v5
v_lshlrev_b32 v6, 16, v137
v_mfma_f32_16x16x32_bf16 v[68:71], v[132:135], a[60:63], v[68:71]
v_and_b32 v7, 0xffff0000, v137
v_mul_f32 v6, v6, v26
v_mfma_f32_16x16x32_bf16 v[72:75], v[132:135], a[64:67], v[72:75]
v_mul_f32 v7, v7, v27
v_cvt_pk_bf16_f32 v137, v6, v7
v_mfma_f32_16x16x32_bf16 v[76:79], v[132:135], a[68:71], v[76:79]
v_lshlrev_b32 v4, 16, v138
v_and_b32 v5, 0xffff0000, v138
v_mfma_f32_16x16x32_bf16 v[80:83], v[132:135], a[72:75], v[80:83]
v_mul_f32 v4, v4, v28
v_mul_f32 v5, v5, v29
v_mfma_f32_16x16x32_bf16 v[84:87], v[132:135], a[76:79], v[84:87]
v_cvt_pk_bf16_f32 v138, v4, v5
v_lshlrev_b32 v6, 16, v139
v_mfma_f32_16x16x32_bf16 v[88:91], v[132:135], a[80:83], v[88:91]
v_and_b32 v7, 0xffff0000, v139
v_mul_f32 v6, v6, v30
v_mfma_f32_16x16x32_bf16 v[92:95], v[132:135], a[84:87], v[92:95]
v_mul_f32 v7, v7, v31
v_cvt_pk_bf16_f32 v139, v6, v7
v_mfma_f32_16x16x32_bf16 v[96:99], v[132:135], a[88:91], v[96:99]
v_mfma_f32_16x16x32_bf16 v[100:103], v[132:135], a[92:95], v[100:103]
v_mfma_f32_16x16x32_bf16 v[56:59], v[136:139], a[96:99], v[56:59]
v_lshlrev_b32 v4, 16, v140
v_and_b32 v5, 0xffff0000, v140
v_mfma_f32_16x16x32_bf16 v[60:63], v[136:139], a[100:103], v[60:63]
v_mul_f32 v4, v4, v32
v_mul_f32 v5, v5, v33
v_mfma_f32_16x16x32_bf16 v[64:67], v[136:139], a[104:107], v[64:67]
v_cvt_pk_bf16_f32 v140, v4, v5
v_lshlrev_b32 v6, 16, v141
v_mfma_f32_16x16x32_bf16 v[68:71], v[136:139], a[108:111], v[68:71]
v_and_b32 v7, 0xffff0000, v141
v_mul_f32 v6, v6, v34
v_mfma_f32_16x16x32_bf16 v[72:75], v[136:139], a[112:115], v[72:75]
v_mul_f32 v7, v7, v35
v_cvt_pk_bf16_f32 v141, v6, v7
v_mfma_f32_16x16x32_bf16 v[76:79], v[136:139], a[116:119], v[76:79]
v_lshlrev_b32 v4, 16, v142
v_and_b32 v5, 0xffff0000, v142
v_mfma_f32_16x16x32_bf16 v[80:83], v[136:139], a[120:123], v[80:83]
v_mul_f32 v4, v4, v36
v_mul_f32 v5, v5, v37
v_mfma_f32_16x16x32_bf16 v[84:87], v[136:139], a[124:127], v[84:87]
v_cvt_pk_bf16_f32 v142, v4, v5
v_lshlrev_b32 v6, 16, v143
v_mfma_f32_16x16x32_bf16 v[88:91], v[136:139], a[128:131], v[88:91]
v_and_b32 v7, 0xffff0000, v143
v_mul_f32 v6, v6, v38
v_mfma_f32_16x16x32_bf16 v[92:95], v[136:139], a[132:135], v[92:95]
v_mul_f32 v7, v7, v39
v_cvt_pk_bf16_f32 v143, v6, v7
v_mfma_f32_16x16x32_bf16 v[96:99], v[136:139], a[136:139], v[96:99]
v_mfma_f32_16x16x32_bf16 v[100:103], v[136:139], a[140:143], v[100:103]
v_mfma_f32_16x16x32_bf16 v[56:59], v[140:143], a[144:147], v[56:59]
v_lshlrev_b32 v4, 16, v144
v_and_b32 v5, 0xffff0000, v144
v_mfma_f32_16x16x32_bf16 v[60:63], v[140:143], a[148:151], v[60:63]
v_mul_f32 v4, v4, v40
v_mul_f32 v5, v5, v41
v_mfma_f32_16x16x32_bf16 v[64:67], v[140:143], a[152:155], v[64:67]
v_cvt_pk_bf16_f32 v144, v4, v5
v_lshlrev_b32 v6, 16, v145
v_mfma_f32_16x16x32_bf16 v[68:71], v[140:143], a[156:159], v[68:71]
v_and_b32 v7, 0xffff0000, v145
v_mul_f32 v6, v6, v42
v_mfma_f32_16x16x32_bf16 v[72:75], v[140:143], a[160:163], v[72:75]
v_mul_f32 v7, v7, v43
v_cvt_pk_bf16_f32 v145, v6, v7
v_mfma_f32_16x16x32_bf16 v[76:79], v[140:143], a[164:167], v[76:79]
v_lshlrev_b32 v4, 16, v146
v_and_b32 v5, 0xffff0000, v146
v_mfma_f32_16x16x32_bf16 v[80:83], v[140:143], a[168:171], v[80:83]
v_mul_f32 v4, v4, v44
v_mul_f32 v5, v5, v45
v_mfma_f32_16x16x32_bf16 v[84:87], v[140:143], a[172:175], v[84:87]
v_cvt_pk_bf16_f32 v146, v4, v5
v_lshlrev_b32 v6, 16, v147
v_mfma_f32_16x16x32_bf16 v[88:91], v[140:143], a[176:179], v[88:91]
v_and_b32 v7, 0xffff0000, v147
v_mul_f32 v6, v6, v46
v_mfma_f32_16x16x32_bf16 v[92:95], v[140:143], a[180:183], v[92:95]
v_mul_f32 v7, v7, v47
v_cvt_pk_bf16_f32 v147, v6, v7
v_mfma_f32_16x16x32_bf16 v[96:99], v[140:143], a[184:187], v[96:99]
v_mfma_f32_16x16x32_bf16 v[100:103], v[140:143], a[188:191], v[100:103]
v_mfma_f32_16x16x32_bf16 v[56:59], v[144:147], a[192:195], v[56:59]
v_lshlrev_b32 v4, 16, v148
v_and_b32 v5, 0xffff0000, v148
v_mfma_f32_16x16x32_bf16 v[60:63], v[144:147], a[196:199], v[60:63]
v_mul_f32 v4, v4, v48
v_mul_f32 v5, v5, v49
v_mfma_f32_16x16x32_bf16 v[64:67], v[144:147], a[200:203], v[64:67]
v_cvt_pk_bf16_f32 v148, v4, v5
v_lshlrev_b32 v6, 16, v149
v_mfma_f32_16x16x32_bf16 v[68:71], v[144:147], a[204:207], v[68:71]
v_and_b32 v7, 0xffff0000, v149
v_mul_f32 v6, v6, v50
v_mfma_f32_16x16x32_bf16 v[72:75], v[144:147], a[208:211], v[72:75]
v_mul_f32 v7, v7, v51
v_cvt_pk_bf16_f32 v149, v6, v7
v_mfma_f32_16x16x32_bf16 v[76:79], v[144:147], a[212:215], v[76:79]
v_lshlrev_b32 v4, 16, v150
v_and_b32 v5, 0xffff0000, v150
v_mfma_f32_16x16x32_bf16 v[80:83], v[144:147], a[216:219], v[80:83]
v_mul_f32 v4, v4, v52
v_mul_f32 v5, v5, v53
v_mfma_f32_16x16x32_bf16 v[84:87], v[144:147], a[220:223], v[84:87]
v_cvt_pk_bf16_f32 v150, v4, v5
v_lshlrev_b32 v6, 16, v151
v_mfma_f32_16x16x32_bf16 v[88:91], v[144:147], a[224:227], v[88:91]
v_and_b32 v7, 0xffff0000, v151
v_mul_f32 v6, v6, v54
v_mfma_f32_16x16x32_bf16 v[92:95], v[144:147], a[228:231], v[92:95]
v_mul_f32 v7, v7, v55
v_cvt_pk_bf16_f32 v151, v6, v7
v_mfma_f32_16x16x32_bf16 v[96:99], v[144:147], a[232:235], v[96:99]
v_mfma_f32_16x16x32_bf16 v[100:103], v[144:147], a[236:239], v[100:103]
v_mfma_f32_16x16x32_bf16 v[56:59], v[148:151], a[240:243], v[56:59]
v_mfma_f32_16x16x32_bf16 v[60:63], v[148:151], a[244:247], v[60:63]
v_mfma_f32_16x16x32_bf16 v[64:67], v[148:151], a[248:251], v[64:67]
v_mfma_f32_16x16x32_bf16 v[68:71], v[148:151], a[252:255], v[68:71]
v_mfma_f32_16x16x32_bf16 v[72:75], v[148:151], v[224:227], v[72:75]
v_mfma_f32_16x16x32_bf16 v[76:79], v[148:151], v[228:231], v[76:79]
v_mfma_f32_16x16x32_bf16 v[80:83], v[148:151], v[232:235], v[80:83]
v_mfma_f32_16x16x32_bf16 v[84:87], v[148:151], v[236:239], v[84:87]
v_mfma_f32_16x16x32_bf16 v[88:91], v[148:151], v[240:243], v[88:91]
v_mfma_f32_16x16x32_bf16 v[92:95], v[148:151], v[244:247], v[92:95]
v_mfma_f32_16x16x32_bf16 v[96:99], v[148:151], v[248:251], v[96:99]
v_mfma_f32_16x16x32_bf16 v[100:103], v[148:151], v[252:255], v[100:103]
s_cmp_eq_u32 s79, 0
s_cbranch_scc1 L_sk0
s_mov_b32 m0, s14
s_add_u32 s55, s76, 4096
buffer_load_dwordx4 v164, s[16:19], s76 offen offset:0 nt lds
buffer_load_dwordx4 v164, s[16:19], s76 offen offset:1024 nt lds
buffer_load_dwordx4 v164, s[16:19], s76 offen offset:2048 nt lds
buffer_load_dwordx4 v164, s[16:19], s76 offen offset:3072 nt lds
s_add_u32 m0, s14, 4096
s_nop 0
buffer_load_dwordx4 v164, s[16:19], s55 offen offset:0 nt lds
buffer_load_dwordx4 v164, s[16:19], s55 offen offset:1024 nt lds
s_add_u32 s14, s14, 24576
s_cmp_ge_u32 s14, s77
s_cselect_b32 s14, s13, s14
s_add_u32 s76, s76, 6291456
L_sk0:
s_nop 7
v_cvt_pk_bf16_f32 v104, v56, v60
v_cvt_pk_bf16_f32 v105, v64, v68
v_cvt_pk_bf16_f32 v106, v72, v76
v_cvt_pk_bf16_f32 v107, v80, v84
v_cvt_pk_bf16_f32 v108, v88, v92
v_cvt_pk_bf16_f32 v109, v96, v100
v_cvt_pk_bf16_f32 v110, v57, v61
v_cvt_pk_bf16_f32 v111, v65, v69
v_cvt_pk_bf16_f32 v112, v73, v77
v_cvt_pk_bf16_f32 v113, v81, v85
v_cvt_pk_bf16_f32 v114, v89, v93
v_cvt_pk_bf16_f32 v115, v97, v101
v_cvt_pk_bf16_f32 v116, v58, v62
v_cvt_pk_bf16_f32 v117, v66, v70
v_cvt_pk_bf16_f32 v118, v74, v78
v_cvt_pk_bf16_f32 v119, v82, v86
v_cvt_pk_bf16_f32 v120, v90, v94
v_cvt_pk_bf16_f32 v121, v98, v102
v_cvt_pk_bf16_f32 v122, v59, v63
v_cvt_pk_bf16_f32 v123, v67, v71
v_cvt_pk_bf16_f32 v124, v75, v79
v_cvt_pk_bf16_f32 v125, v83, v87
v_cvt_pk_bf16_f32 v126, v91, v95
v_cvt_pk_bf16_f32 v127, v99, v103
buffer_store_dwordx4 v[104:107], v2, s[20:23], s72 offen offset:0 sc1
buffer_store_dwordx2 v[108:109], v3, s[20:23], s72 offen offset:0 sc1
buffer_store_dwordx4 v[110:113], v2, s[20:23], s72 offen offset:384 sc1
buffer_store_dwordx2 v[114:115], v3, s[20:23], s72 offen offset:384 sc1
buffer_store_dwordx4 v[116:119], v2, s[20:23], s72 offen offset:768 sc1
buffer_store_dwordx2 v[120:121], v3, s[20:23], s72 offen offset:768 sc1
buffer_store_dwordx4 v[122:125], v2, s[20:23], s72 offen offset:1152 sc1
buffer_store_dwordx2 v[126:127], v3, s[20:23], s72 offen offset:1152 sc1
s_add_u32 s72, s72, 6291456
s_waitcnt vmcnt(8)
s_cmp_eq_u32 s53, 0
s_cbranch_scc1 L_np2
v_readfirstlane_b32 s54, v166
s_cmp_eq_u32 s54, 0
s_cselect_b32 s53, 1, 0
s_cbranch_scc0 L_np2
v_mov_b32 v166, 0
s_mov_b64 exec, 1
buffer_atomic_swap v166, off, s[56:59], s50 sc0 sc1
s_mov_b64 exec, -1
L_np2:
s_mov_b32 s78, 1
s_mov_b32 s43, 876
s_cmp_eq_u32 s3, 1
s_cselect_b32 s43, 436, s43
s_cmp_eq_u32 s3, 2
s_cselect_b32 s43, 728, s43
s_cmp_eq_u32 s3, 3
s_cselect_b32 s43, 876, s43
s_branch L_sbody
L_sloop:
s_waitcnt vmcnt(22)
s_bitcmp1_b32 s43, s78
s_cbranch_scc0 L_sbody
s_waitcnt vmcnt(8)
L_sbody:
v_add_u32 v158, s15, v152
v_add_u32 v159, s15, v153
v_add_u32 v160, s15, v154
v_add_u32 v161, s15, v155
v_add_u32 v162, s15, v156
v_add_u32 v163, s15, v157
ds_read_b128 v[128:131], v158
ds_read_b128 v[132:135], v159
ds_read_b128 v[136:139], v160
ds_read_b128 v[140:143], v161
ds_read_b128 v[144:147], v162
ds_read_b128 v[148:151], v163
s_add_u32 s15, s15, 24576
s_cmp_ge_u32 s15, s77
s_cselect_b32 s15, s13, s15
s_waitcnt lgkmcnt(5)
v_lshlrev_b32 v4, 16, v128
v_and_b32 v5, 0xffff0000, v128
v_mul_f32 v4, v4, v8
v_mul_f32 v5, v5, v9
v_cvt_pk_bf16_f32 v128, v4, v5
v_lshlrev_b32 v6, 16, v129
v_and_b32 v7, 0xffff0000, v129
v_mul_f32 v6, v6, v10
v_mul_f32 v7, v7, v11
v_cvt_pk_bf16_f32 v129, v6, v7
v_lshlrev_b32 v4, 16, v130
v_and_b32 v5, 0xffff0000, v130
v_mul_f32 v4, v4, v12
v_mul_f32 v5, v5, v13
v_cvt_pk_bf16_f32 v130, v4, v5
v_lshlrev_b32 v6, 16, v131
v_and_b32 v7, 0xffff0000, v131
v_mul_f32 v6, v6, v14
v_mul_f32 v7, v7, v15
v_cvt_pk_bf16_f32 v131, v6, v7
s_waitcnt lgkmcnt(0)
s_nop 0
v_mfma_f32_16x16x32_bf16 v[56:59], v[128:131], a[0:3], 0
v_lshlrev_b32 v4, 16, v132
v_and_b32 v5, 0xffff0000, v132
v_mfma_f32_16x16x32_bf16 v[60:63], v[128:131], a[4:7], 0
v_mul_f32 v4, v4, v16
v_mul_f32 v5, v5, v17
v_mfma_f32_16x16x32_bf16 v[64:67], v[128:131], a[8:11], 0
v_cvt_pk_bf16_f32 v132, v4, v5
v_lshlrev_b32 v6, 16, v133
v_mfma_f32_16x16x32_bf16 v[68:71], v[128:131], a[12:15], 0
v_and_b32 v7, 0xffff0000, v133
v_mul_f32 v6, v6, v18
v_mfma_f32_16x16x32_bf16 v[72:75], v[128:131], a[16:19], 0
v_mul_f32 v7, v7, v19
v_cvt_pk_bf16_f32 v133, v6, v7
v_mfma_f32_16x16x32_bf16 v[76:79], v[128:131], a[20:23], 0
v_lshlrev_b32 v4, 16, v134
v_and_b32 v5, 0xffff0000, v134
v_mfma_f32_16x16x32_bf16 v[80:83], v[128:131], a[24:27], 0
v_mul_f32 v4, v4, v20
v_mul_f32 v5, v5, v21
v_mfma_f32_16x16x32_bf16 v[84:87], v[128:131], a[28:31], 0
v_cvt_pk_bf16_f32 v134, v4, v5
v_lshlrev_b32 v6, 16, v135
v_mfma_f32_16x16x32_bf16 v[88:91], v[128:131], a[32:35], 0
v_and_b32 v7, 0xffff0000, v135
v_mul_f32 v6, v6, v22
v_mfma_f32_16x16x32_bf16 v[92:95], v[128:131], a[36:39], 0
v_mul_f32 v7, v7, v23
v_cvt_pk_bf16_f32 v135, v6, v7
v_mfma_f32_16x16x32_bf16 v[96:99], v[128:131], a[40:43], 0
v_mfma_f32_16x16x32_bf16 v[100:103], v[128:131], a[44:47], 0
v_mfma_f32_16x16x32_bf16 v[56:59], v[132:135], a[48:51], v[56:59]
v_lshlrev_b32 v4, 16, v136
v_and_b32 v5, 0xffff0000, v136
v_mfma_f32_16x16x32_bf16 v[60:63], v[132:135], a[52:55], v[60:63]
v_mul_f32 v4, v4, v24
v_mul_f32 v5, v5, v25
v_mfma_f32_16x16x32_bf16 v[64:67], v[132:135], a[56:59], v[64:67]
v_cvt_pk_bf16_f32 v136, v4, v5
v_lshlrev_b32 v6, 16, v137
v_mfma_f32_16x16x32_bf16 v[68:71], v[132:135], a[60:63], v[68:71]
v_and_b32 v7, 0xffff0000, v137
v_mul_f32 v6, v6, v26
v_mfma_f32_16x16x32_bf16 v[72:75], v[132:135], a[64:67], v[72:75]
v_mul_f32 v7, v7, v27
v_cvt_pk_bf16_f32 v137, v6, v7
v_mfma_f32_16x16x32_bf16 v[76:79], v[132:135], a[68:71], v[76:79]
v_lshlrev_b32 v4, 16, v138
v_and_b32 v5, 0xffff0000, v138
v_mfma_f32_16x16x32_bf16 v[80:83], v[132:135], a[72:75], v[80:83]
v_mul_f32 v4, v4, v28
v_mul_f32 v5, v5, v29
v_mfma_f32_16x16x32_bf16 v[84:87], v[132:135], a[76:79], v[84:87]
v_cvt_pk_bf16_f32 v138, v4, v5
v_lshlrev_b32 v6, 16, v139
v_mfma_f32_16x16x32_bf16 v[88:91], v[132:135], a[80:83], v[88:91]
v_and_b32 v7, 0xffff0000, v139
v_mul_f32 v6, v6, v30
v_mfma_f32_16x16x32_bf16 v[92:95], v[132:135], a[84:87], v[92:95]
v_mul_f32 v7, v7, v31
v_cvt_pk_bf16_f32 v139, v6, v7
v_mfma_f32_16x16x32_bf16 v[96:99], v[132:135], a[88:91], v[96:99]
v_mfma_f32_16x16x32_bf16 v[100:103], v[132:135], a[92:95], v[100:103]
v_mfma_f32_16x16x32_bf16 v[56:59], v[136:139], a[96:99], v[56:59]
v_lshlrev_b32 v4, 16, v140
v_and_b32 v5, 0xffff0000, v140
v_mfma_f32_16x16x32_bf16 v[60:63], v[136:139], a[100:103], v[60:63]
v_mul_f32 v4, v4, v32
v_mul_f32 v5, v5, v33
v_mfma_f32_16x16x32_bf16 v[64:67], v[136:139], a[104:107], v[64:67]
v_cvt_pk_bf16_f32 v140, v4, v5
v_lshlrev_b32 v6, 16, v141
v_mfma_f32_16x16x32_bf16 v[68:71], v[136:139], a[108:111], v[68:71]
v_and_b32 v7, 0xffff0000, v141
v_mul_f32 v6, v6, v34
v_mfma_f32_16x16x32_bf16 v[72:75], v[136:139], a[112:115], v[72:75]
v_mul_f32 v7, v7, v35
v_cvt_pk_bf16_f32 v141, v6, v7
v_mfma_f32_16x16x32_bf16 v[76:79], v[136:139], a[116:119], v[76:79]
v_lshlrev_b32 v4, 16, v142
v_and_b32 v5, 0xffff0000, v142
v_mfma_f32_16x16x32_bf16 v[80:83], v[136:139], a[120:123], v[80:83]
v_mul_f32 v4, v4, v36
v_mul_f32 v5, v5, v37
v_mfma_f32_16x16x32_bf16 v[84:87], v[136:139], a[124:127], v[84:87]
v_cvt_pk_bf16_f32 v142, v4, v5
v_lshlrev_b32 v6, 16, v143
v_mfma_f32_16x16x32_bf16 v[88:91], v[136:139], a[128:131], v[88:91]
v_and_b32 v7, 0xffff0000, v143
v_mul_f32 v6, v6, v38
v_mfma_f32_16x16x32_bf16 v[92:95], v[136:139], a[132:135], v[92:95]
v_mul_f32 v7, v7, v39
v_cvt_pk_bf16_f32 v143, v6, v7
v_mfma_f32_16x16x32_bf16 v[96:99], v[136:139], a[136:139], v[96:99]
v_mfma_f32_16x16x32_bf16 v[100:103], v[136:139], a[140:143], v[100:103]
v_mfma_f32_16x16x32_bf16 v[56:59], v[140:143], a[144:147], v[56:59]
v_lshlrev_b32 v4, 16, v144
v_and_b32 v5, 0xffff0000, v144
v_mfma_f32_16x16x32_bf16 v[60:63], v[140:143], a[148:151], v[60:63]
v_mul_f32 v4, v4, v40
v_mul_f32 v5, v5, v41
v_mfma_f32_16x16x32_bf16 v[64:67], v[140:143], a[152:155], v[64:67]
v_cvt_pk_bf16_f32 v144, v4, v5
v_lshlrev_b32 v6, 16, v145
v_mfma_f32_16x16x32_bf16 v[68:71], v[140:143], a[156:159], v[68:71]
v_and_b32 v7, 0xffff0000, v145
v_mul_f32 v6, v6, v42
v_mfma_f32_16x16x32_bf16 v[72:75], v[140:143], a[160:163], v[72:75]
v_mul_f32 v7, v7, v43
v_cvt_pk_bf16_f32 v145, v6, v7
v_mfma_f32_16x16x32_bf16 v[76:79], v[140:143], a[164:167], v[76:79]
v_lshlrev_b32 v4, 16, v146
v_and_b32 v5, 0xffff0000, v146
v_mfma_f32_16x16x32_bf16 v[80:83], v[140:143], a[168:171], v[80:83]
v_mul_f32 v4, v4, v44
v_mul_f32 v5, v5, v45
v_mfma_f32_16x16x32_bf16 v[84:87], v[140:143], a[172:175], v[84:87]
v_cvt_pk_bf16_f32 v146, v4, v5
v_lshlrev_b32 v6, 16, v147
v_mfma_f32_16x16x32_bf16 v[88:91], v[140:143], a[176:179], v[88:91]
v_and_b32 v7, 0xffff0000, v147
v_mul_f32 v6, v6, v46
v_mfma_f32_16x16x32_bf16 v[92:95], v[140:143], a[180:183], v[92:95]
v_mul_f32 v7, v7, v47
v_cvt_pk_bf16_f32 v147, v6, v7
v_mfma_f32_16x16x32_bf16 v[96:99], v[140:143], a[184:187], v[96:99]
v_mfma_f32_16x16x32_bf16 v[100:103], v[140:143], a[188:191], v[100:103]
v_mfma_f32_16x16x32_bf16 v[56:59], v[144:147], a[192:195], v[56:59]
v_lshlrev_b32 v4, 16, v148
v_and_b32 v5, 0xffff0000, v148
v_mfma_f32_16x16x32_bf16 v[60:63], v[144:147], a[196:199], v[60:63]
v_mul_f32 v4, v4, v48
v_mul_f32 v5, v5, v49
v_mfma_f32_16x16x32_bf16 v[64:67], v[144:147], a[200:203], v[64:67]
v_cvt_pk_bf16_f32 v148, v4, v5
v_lshlrev_b32 v6, 16, v149
v_mfma_f32_16x16x32_bf16 v[68:71], v[144:147], a[204:207], v[68:71]
v_and_b32 v7, 0xffff0000, v149
v_mul_f32 v6, v6, v50
v_mfma_f32_16x16x32_bf16 v[72:75], v[144:147], a[208:211], v[72:75]
v_mul_f32 v7, v7, v51
v_cvt_pk_bf16_f32 v149, v6, v7
v_mfma_f32_16x16x32_bf16 v[76:79], v[144:147], a[212:215], v[76:79]
v_lshlrev_b32 v4, 16, v150
v_and_b32 v5, 0xffff0000, v150
v_mfma_f32_16x16x32_bf16 v[80:83], v[144:147], a[216:219], v[80:83]
v_mul_f32 v4, v4, v52
v_mul_f32 v5, v5, v53
v_mfma_f32_16x16x32_bf16 v[84:87], v[144:147], a[220:223], v[84:87]
v_cvt_pk_bf16_f32 v150, v4, v5
v_lshlrev_b32 v6, 16, v151
v_mfma_f32_16x16x32_bf16 v[88:91], v[144:147], a[224:227], v[88:91]
v_and_b32 v7, 0xffff0000, v151
v_mul_f32 v6, v6, v54
v_mfma_f32_16x16x32_bf16 v[92:95], v[144:147], a[228:231], v[92:95]
v_mul_f32 v7, v7, v55
v_cvt_pk_bf16_f32 v151, v6, v7
v_mfma_f32_16x16x32_bf16 v[96:99], v[144:147], a[232:235], v[96:99]
v_mfma_f32_16x16x32_bf16 v[100:103], v[144:147], a[236:239], v[100:103]
v_mfma_f32_16x16x32_bf16 v[56:59], v[148:151], a[240:243], v[56:59]
v_mfma_f32_16x16x32_bf16 v[60:63], v[148:151], a[244:247], v[60:63]
v_mfma_f32_16x16x32_bf16 v[64:67], v[148:151], a[248:251], v[64:67]
v_mfma_f32_16x16x32_bf16 v[68:71], v[148:151], a[252:255], v[68:71]
v_mfma_f32_16x16x32_bf16 v[72:75], v[148:151], v[224:227], v[72:75]
v_mfma_f32_16x16x32_bf16 v[76:79], v[148:151], v[228:231], v[76:79]
v_mfma_f32_16x16x32_bf16 v[80:83], v[148:151], v[232:235], v[80:83]
v_mfma_f32_16x16x32_bf16 v[84:87], v[148:151], v[236:239], v[84:87]
v_mfma_f32_16x16x32_bf16 v[88:91], v[148:151], v[240:243], v[88:91]
v_mfma_f32_16x16x32_bf16 v[92:95], v[148:151], v[244:247], v[92:95]
v_mfma_f32_16x16x32_bf16 v[96:99], v[148:151], v[248:251], v[96:99]
v_mfma_f32_16x16x32_bf16 v[100:103], v[148:151], v[252:255], v[100:103]
s_cmp_ge_u32 s78, 8
s_cbranch_scc1 L_trans
s_cmp_eq_u32 s78, 2
s_cbranch_scc1 L_pub
L_sgo:
s_cmp_eq_u32 s78, s79
s_cbranch_scc1 L_sskip
s_mov_b32 m0, s14
s_add_u32 s55, s76, 4096
buffer_load_dwordx4 v164, s[16:19], s76 offen offset:0 nt lds
buffer_load_dwordx4 v164, s[16:19], s76 offen offset:1024 nt lds
buffer_load_dwordx4 v164, s[16:19], s76 offen offset:2048 nt lds
buffer_load_dwordx4 v164, s[16:19], s76 offen offset:3072 nt lds
s_add_u32 m0, s14, 4096
s_nop 0
buffer_load_dwordx4 v164, s[16:19], s55 offen offset:0 nt lds
buffer_load_dwordx4 v164, s[16:19], s55 offen offset:1024 nt lds
s_add_u32 s14, s14, 24576
s_cmp_ge_u32 s14, s77
s_cselect_b32 s14, s13, s14
s_add_u32 s76, s76, 6291456
L_sskip:
s_nop 7
v_cvt_pk_bf16_f32 v104, v56, v60
v_cvt_pk_bf16_f32 v105, v64, v68
v_cvt_pk_bf16_f32 v106, v72, v76
v_cvt_pk_bf16_f32 v107, v80, v84
v_cvt_pk_bf16_f32 v108, v88, v92
v_cvt_pk_bf16_f32 v109, v96, v100
v_cvt_pk_bf16_f32 v110, v57, v61
v_cvt_pk_bf16_f32 v111, v65, v69
v_cvt_pk_bf16_f32 v112, v73, v77
v_cvt_pk_bf16_f32 v113, v81, v85
v_cvt_pk_bf16_f32 v114, v89, v93
v_cvt_pk_bf16_f32 v115, v97, v101
v_cvt_pk_bf16_f32 v116, v58, v62
v_cvt_pk_bf16_f32 v117, v66, v70
v_cvt_pk_bf16_f32 v118, v74, v78
v_cvt_pk_bf16_f32 v119, v82, v86
v_cvt_pk_bf16_f32 v120, v90, v94
v_cvt_pk_bf16_f32 v121, v98, v102
v_cvt_pk_bf16_f32 v122, v59, v63
v_cvt_pk_bf16_f32 v123, v67, v71
v_cvt_pk_bf16_f32 v124, v75, v79
v_cvt_pk_bf16_f32 v125, v83, v87
v_cvt_pk_bf16_f32 v126, v91, v95
v_cvt_pk_bf16_f32 v127, v99, v103
buffer_store_dwordx4 v[104:107], v2, s[20:23], s72 offen offset:0 sc1
buffer_store_dwordx2 v[108:109], v3, s[20:23], s72 offen offset:0 sc1
buffer_store_dwordx4 v[110:113], v2, s[20:23], s72 offen offset:384 sc1
buffer_store_dwordx2 v[114:115], v3, s[20:23], s72 offen offset:384 sc1
buffer_store_dwordx4 v[116:119], v2, s[20:23], s72 offen offset:768 sc1
buffer_store_dwordx2 v[120:121], v3, s[20:23], s72 offen offset:768 sc1
buffer_store_dwordx4 v[122:125], v2, s[20:23], s72 offen offset:1152 sc1
buffer_store_dwordx2 v[126:127], v3, s[20:23], s72 offen offset:1152 sc1
s_add_u32 s72, s72, 6291456
s_add_u32 s78, s78, 1
s_cmp_lt_u32 s78, 10
s_cbranch_scc1 L_sloop
s_add_u32 s73, s72, 6291456
s_mov_b32 s74, 0
L_dloop:
s_cmp_ge_u32 s72, 100663296
s_cbranch_scc1 L_fin
s_waitcnt vmcnt(22)
v_add_u32 v158, s15, v152
v_add_u32 v159, s15, v153
v_add_u32 v160, s15, v154
v_add_u32 v161, s15, v155
v_add_u32 v162, s15, v156
v_add_u32 v163, s15, v157
ds_read_b128 v[128:131], v158
ds_read_b128 v[132:135], v159
ds_read_b128 v[136:139], v160
ds_read_b128 v[140:143], v161
ds_read_b128 v[144:147], v162
ds_read_b128 v[148:151], v163
s_add_u32 s15, s15, 24576
s_cmp_ge_u32 s15, s77
s_cselect_b32 s15, s13, s15
s_waitcnt lgkmcnt(5)
v_lshlrev_b32 v4, 16, v128
v_and_b32 v5, 0xffff0000, v128
v_mul_f32 v4, v4, v8
v_mul_f32 v5, v5, v9
v_cvt_pk_bf16_f32 v128, v4, v5
v_lshlrev_b32 v6, 16, v129
v_and_b32 v7, 0xffff0000, v129
v_mul_f32 v6, v6, v10
v_mul_f32 v7, v7, v11
v_cvt_pk_bf16_f32 v129, v6, v7
v_lshlrev_b32 v4, 16, v130
v_and_b32 v5, 0xffff0000, v130
v_mul_f32 v4, v4, v12
v_mul_f32 v5, v5, v13
v_cvt_pk_bf16_f32 v130, v4, v5
v_lshlrev_b32 v6, 16, v131
v_and_b32 v7, 0xffff0000, v131
v_mul_f32 v6, v6, v14
v_mul_f32 v7, v7, v15
v_cvt_pk_bf16_f32 v131, v6, v7
s_waitcnt lgkmcnt(0)
s_nop 0
v_mfma_f32_16x16x32_bf16 v[56:59], v[128:131], a[0:3], 0
v_lshlrev_b32 v4, 16, v132
v_and_b32 v5, 0xffff0000, v132
v_mfma_f32_16x16x32_bf16 v[60:63], v[128:131], a[4:7], 0
v_mul_f32 v4, v4, v16
v_mul_f32 v5, v5, v17
v_mfma_f32_16x16x32_bf16 v[64:67], v[128:131], a[8:11], 0
v_cvt_pk_bf16_f32 v132, v4, v5
v_lshlrev_b32 v6, 16, v133
v_mfma_f32_16x16x32_bf16 v[68:71], v[128:131], a[12:15], 0
v_and_b32 v7, 0xffff0000, v133
v_mul_f32 v6, v6, v18
v_mfma_f32_16x16x32_bf16 v[72:75], v[128:131], a[16:19], 0
v_mul_f32 v7, v7, v19
v_cvt_pk_bf16_f32 v133, v6, v7
v_mfma_f32_16x16x32_bf16 v[76:79], v[128:131], a[20:23], 0
v_lshlrev_b32 v4, 16, v134
v_and_b32 v5, 0xffff0000, v134
v_mfma_f32_16x16x32_bf16 v[80:83], v[128:131], a[24:27], 0
v_mul_f32 v4, v4, v20
v_mul_f32 v5, v5, v21
v_mfma_f32_16x16x32_bf16 v[84:87], v[128:131], a[28:31], 0
v_cvt_pk_bf16_f32 v134, v4, v5
v_lshlrev_b32 v6, 16, v135
v_mfma_f32_16x16x32_bf16 v[88:91], v[128:131], a[32:35], 0
v_and_b32 v7, 0xffff0000, v135
v_mul_f32 v6, v6, v22
v_mfma_f32_16x16x32_bf16 v[92:95], v[128:131], a[36:39], 0
v_mul_f32 v7, v7, v23
v_cvt_pk_bf16_f32 v135, v6, v7
v_mfma_f32_16x16x32_bf16 v[96:99], v[128:131], a[40:43], 0
v_mfma_f32_16x16x32_bf16 v[100:103], v[128:131], a[44:47], 0
v_mfma_f32_16x16x32_bf16 v[56:59], v[132:135], a[48:51], v[56:59]
v_lshlrev_b32 v4, 16, v136
v_and_b32 v5, 0xffff0000, v136
v_mfma_f32_16x16x32_bf16 v[60:63], v[132:135], a[52:55], v[60:63]
v_mul_f32 v4, v4, v24
v_mul_f32 v5, v5, v25
v_mfma_f32_16x16x32_bf16 v[64:67], v[132:135], a[56:59], v[64:67]
v_cvt_pk_bf16_f32 v136, v4, v5
v_lshlrev_b32 v6, 16, v137
v_mfma_f32_16x16x32_bf16 v[68:71], v[132:135], a[60:63], v[68:71]
v_and_b32 v7, 0xffff0000, v137
v_mul_f32 v6, v6, v26
v_mfma_f32_16x16x32_bf16 v[72:75], v[132:135], a[64:67], v[72:75]
v_mul_f32 v7, v7, v27
v_cvt_pk_bf16_f32 v137, v6, v7
v_mfma_f32_16x16x32_bf16 v[76:79], v[132:135], a[68:71], v[76:79]
v_lshlrev_b32 v4, 16, v138
v_and_b32 v5, 0xffff0000, v138
v_mfma_f32_16x16x32_bf16 v[80:83], v[132:135], a[72:75], v[80:83]
v_mul_f32 v4, v4, v28
v_mul_f32 v5, v5, v29
v_mfma_f32_16x16x32_bf16 v[84:87], v[132:135], a[76:79], v[84:87]
v_cvt_pk_bf16_f32 v138, v4, v5
v_lshlrev_b32 v6, 16, v139
v_mfma_f32_16x16x32_bf16 v[88:91], v[132:135], a[80:83], v[88:91]
v_and_b32 v7, 0xffff0000, v139
v_mul_f32 v6, v6, v30
v_mfma_f32_16x16x32_bf16 v[92:95], v[132:135], a[84:87], v[92:95]
v_mul_f32 v7, v7, v31
v_cvt_pk_bf16_f32 v139, v6, v7
v_mfma_f32_16x16x32_bf16 v[96:99], v[132:135], a[88:91], v[96:99]
v_mfma_f32_16x16x32_bf16 v[100:103], v[132:135], a[92:95], v[100:103]
v_mfma_f32_16x16x32_bf16 v[56:59], v[136:139], a[96:99], v[56:59]
v_lshlrev_b32 v4, 16, v140
v_and_b32 v5, 0xffff0000, v140
v_mfma_f32_16x16x32_bf16 v[60:63], v[136:139], a[100:103], v[60:63]
v_mul_f32 v4, v4, v32
v_mul_f32 v5, v5, v33
v_mfma_f32_16x16x32_bf16 v[64:67], v[136:139], a[104:107], v[64:67]
v_cvt_pk_bf16_f32 v140, v4, v5
v_lshlrev_b32 v6, 16, v141
v_mfma_f32_16x16x32_bf16 v[68:71], v[136:139], a[108:111], v[68:71]
v_and_b32 v7, 0xffff0000, v141
v_mul_f32 v6, v6, v34
v_mfma_f32_16x16x32_bf16 v[72:75], v[136:139], a[112:115], v[72:75]
v_mul_f32 v7, v7, v35
v_cvt_pk_bf16_f32 v141, v6, v7
v_mfma_f32_16x16x32_bf16 v[76:79], v[136:139], a[116:119], v[76:79]
v_lshlrev_b32 v4, 16, v142
v_and_b32 v5, 0xffff0000, v142
v_mfma_f32_16x16x32_bf16 v[80:83], v[136:139], a[120:123], v[80:83]
v_mul_f32 v4, v4, v36
v_mul_f32 v5, v5, v37
v_mfma_f32_16x16x32_bf16 v[84:87], v[136:139], a[124:127], v[84:87]
v_cvt_pk_bf16_f32 v142, v4, v5
v_lshlrev_b32 v6, 16, v143
v_mfma_f32_16x16x32_bf16 v[88:91], v[136:139], a[128:131], v[88:91]
v_and_b32 v7, 0xffff0000, v143
v_mul_f32 v6, v6, v38
v_mfma_f32_16x16x32_bf16 v[92:95], v[136:139], a[132:135], v[92:95]
v_mul_f32 v7, v7, v39
v_cvt_pk_bf16_f32 v143, v6, v7
v_mfma_f32_16x16x32_bf16 v[96:99], v[136:139], a[136:139], v[96:99]
v_mfma_f32_16x16x32_bf16 v[100:103], v[136:139], a[140:143], v[100:103]
v_mfma_f32_16x16x32_bf16 v[56:59], v[140:143], a[144:147], v[56:59]
v_lshlrev_b32 v4, 16, v144
v_and_b32 v5, 0xffff0000, v144
v_mfma_f32_16x16x32_bf16 v[60:63], v[140:143], a[148:151], v[60:63]
v_mul_f32 v4, v4, v40
v_mul_f32 v5, v5, v41
v_mfma_f32_16x16x32_bf16 v[64:67], v[140:143], a[152:155], v[64:67]
v_cvt_pk_bf16_f32 v144, v4, v5
v_lshlrev_b32 v6, 16, v145
v_mfma_f32_16x16x32_bf16 v[68:71], v[140:143], a[156:159], v[68:71]
v_and_b32 v7, 0xffff0000, v145
v_mul_f32 v6, v6, v42
v_mfma_f32_16x16x32_bf16 v[72:75], v[140:143], a[160:163], v[72:75]
v_mul_f32 v7, v7, v43
v_cvt_pk_bf16_f32 v145, v6, v7
v_mfma_f32_16x16x32_bf16 v[76:79], v[140:143], a[164:167], v[76:79]
v_lshlrev_b32 v4, 16, v146
v_and_b32 v5, 0xffff0000, v146
v_mfma_f32_16x16x32_bf16 v[80:83], v[140:143], a[168:171], v[80:83]
v_mul_f32 v4, v4, v44
v_mul_f32 v5, v5, v45
v_mfma_f32_16x16x32_bf16 v[84:87], v[140:143], a[172:175], v[84:87]
v_cvt_pk_bf16_f32 v146, v4, v5
v_lshlrev_b32 v6, 16, v147
v_mfma_f32_16x16x32_bf16 v[88:91], v[140:143], a[176:179], v[88:91]
v_and_b32 v7, 0xffff0000, v147
v_mul_f32 v6, v6, v46
v_mfma_f32_16x16x32_bf16 v[92:95], v[140:143], a[180:183], v[92:95]
v_mul_f32 v7, v7, v47
v_cvt_pk_bf16_f32 v147, v6, v7
v_mfma_f32_16x16x32_bf16 v[96:99], v[140:143], a[184:187], v[96:99]
v_mfma_f32_16x16x32_bf16 v[100:103], v[140:143], a[188:191], v[100:103]
v_mfma_f32_16x16x32_bf16 v[56:59], v[144:147], a[192:195], v[56:59]
v_lshlrev_b32 v4, 16, v148
v_and_b32 v5, 0xffff0000, v148
v_mfma_f32_16x16x32_bf16 v[60:63], v[144:147], a[196:199], v[60:63]
v_mul_f32 v4, v4, v48
v_mul_f32 v5, v5, v49
v_mfma_f32_16x16x32_bf16 v[64:67], v[144:147], a[200:203], v[64:67]
v_cvt_pk_bf16_f32 v148, v4, v5
v_lshlrev_b32 v6, 16, v149
v_mfma_f32_16x16x32_bf16 v[68:71], v[144:147], a[204:207], v[68:71]
v_and_b32 v7, 0xffff0000, v149
v_mul_f32 v6, v6, v50
v_mfma_f32_16x16x32_bf16 v[72:75], v[144:147], a[208:211], v[72:75]
v_mul_f32 v7, v7, v51
v_cvt_pk_bf16_f32 v149, v6, v7
v_mfma_f32_16x16x32_bf16 v[76:79], v[144:147], a[212:215], v[76:79]
v_lshlrev_b32 v4, 16, v150
v_and_b32 v5, 0xffff0000, v150
v_mfma_f32_16x16x32_bf16 v[80:83], v[144:147], a[216:219], v[80:83]
v_mul_f32 v4, v4, v52
v_mul_f32 v5, v5, v53
v_mfma_f32_16x16x32_bf16 v[84:87], v[144:147], a[220:223], v[84:87]
v_cvt_pk_bf16_f32 v150, v4, v5
v_lshlrev_b32 v6, 16, v151
v_mfma_f32_16x16x32_bf16 v[88:91], v[144:147], a[224:227], v[88:91]
v_and_b32 v7, 0xffff0000, v151
v_mul_f32 v6, v6, v54
v_mfma_f32_16x16x32_bf16 v[92:95], v[144:147], a[228:231], v[92:95]
v_mul_f32 v7, v7, v55
v_cvt_pk_bf16_f32 v151, v6, v7
v_mfma_f32_16x16x32_bf16 v[96:99], v[144:147], a[232:235], v[96:99]
v_mfma_f32_16x16x32_bf16 v[100:103], v[144:147], a[236:239], v[100:103]
v_mfma_f32_16x16x32_bf16 v[56:59], v[148:151], a[240:243], v[56:59]
v_mfma_f32_16x16x32_bf16 v[60:63], v[148:151], a[244:247], v[60:63]
v_mfma_f32_16x16x32_bf16 v[64:67], v[148:151], a[248:251], v[64:67]
v_mfma_f32_16x16x32_bf16 v[68:71], v[148:151], a[252:255], v[68:71]
v_mfma_f32_16x16x32_bf16 v[72:75], v[148:151], v[224:227], v[72:75]
v_mfma_f32_16x16x32_bf16 v[76:79], v[148:151], v[228:231], v[76:79]
v_mfma_f32_16x16x32_bf16 v[80:83], v[148:151], v[232:235], v[80:83]
v_mfma_f32_16x16x32_bf16 v[84:87], v[148:151], v[236:239], v[84:87]
v_mfma_f32_16x16x32_bf16 v[88:91], v[148:151], v[240:243], v[88:91]
v_mfma_f32_16x16x32_bf16 v[92:95], v[148:151], v[244:247], v[92:95]
v_mfma_f32_16x16x32_bf16 v[96:99], v[148:151], v[248:251], v[96:99]
v_mfma_f32_16x16x32_bf16 v[100:103], v[148:151], v[252:255], v[100:103]
s_cmp_ge_u32 s73, 100663296
s_cbranch_scc1 L_dlast
s_waitcnt vmcnt(14)
v_readfirstlane_b32 s54, v168
s_mov_b32 s76, 100663296
s_cmp_lt_u32 s54, 256
s_cbranch_scc0 L_dinv
v_mov_b32 v168, 1
s_mov_b64 exec, 1
buffer_atomic_add v168, off, s[56:59], s50 sc0 sc1
s_mov_b64 exec, -1
s_mul_i32 s76, s54, 98304
s_add_u32 s76, s76, s52
L_dinv:
s_mov_b32 m0, s14
s_add_u32 s55, s76, 4096
buffer_load_dwordx4 v164, s[16:19], s76 offen offset:0 nt lds
buffer_load_dwordx4 v164, s[16:19], s76 offen offset:1024 nt lds
buffer_load_dwordx4 v164, s[16:19], s76 offen offset:2048 nt lds
buffer_load_dwordx4 v164, s[16:19], s76 offen offset:3072 nt lds
s_add_u32 m0, s14, 4096
s_nop 0
buffer_load_dwordx4 v164, s[16:19], s55 offen offset:0 nt lds
buffer_load_dwordx4 v164, s[16:19], s55 offen offset:1024 nt lds
s_add_u32 s14, s14, 24576
s_cmp_ge_u32 s14, s77
s_cselect_b32 s14, s13, s14
L_dlast:
s_nop 5
v_cvt_pk_bf16_f32 v104, v56, v60
v_cvt_pk_bf16_f32 v105, v64, v68
v_cvt_pk_bf16_f32 v106, v72, v76
v_cvt_pk_bf16_f32 v107, v80, v84
v_cvt_pk_bf16_f32 v108, v88, v92
v_cvt_pk_bf16_f32 v109, v96, v100
v_cvt_pk_bf16_f32 v110, v57, v61
v_cvt_pk_bf16_f32 v111, v65, v69
v_cvt_pk_bf16_f32 v112, v73, v77
v_cvt_pk_bf16_f32 v113, v81, v85
v_cvt_pk_bf16_f32 v114, v89, v93
v_cvt_pk_bf16_f32 v115, v97, v101
v_cvt_pk_bf16_f32 v116, v58, v62
v_cvt_pk_bf16_f32 v117, v66, v70
v_cvt_pk_bf16_f32 v118, v74, v78
v_cvt_pk_bf16_f32 v119, v82, v86
v_cvt_pk_bf16_f32 v120, v90, v94
v_cvt_pk_bf16_f32 v121, v98, v102
v_cvt_pk_bf16_f32 v122, v59, v63
v_cvt_pk_bf16_f32 v123, v67, v71
v_cvt_pk_bf16_f32 v124, v75, v79
v_cvt_pk_bf16_f32 v125, v83, v87
v_cvt_pk_bf16_f32 v126, v91, v95
v_cvt_pk_bf16_f32 v127, v99, v103
buffer_store_dwordx4 v[104:107], v2, s[20:23], s72 offen offset:0 sc1
buffer_store_dwordx2 v[108:109], v3, s[20:23], s72 offen offset:0 sc1
buffer_store_dwordx4 v[110:113], v2, s[20:23], s72 offen offset:384 sc1
buffer_store_dwordx2 v[114:115], v3, s[20:23], s72 offen offset:384 sc1
buffer_store_dwordx4 v[116:119], v2, s[20:23], s72 offen offset:768 sc1
buffer_store_dwordx2 v[120:121], v3, s[20:23], s72 offen offset:768 sc1
buffer_store_dwordx4 v[122:125], v2, s[20:23], s72 offen offset:1152 sc1
buffer_store_dwordx2 v[126:127], v3, s[20:23], s72 offen offset:1152 sc1
s_mov_b32 s72, s73
s_mov_b32 s73, s76
s_add_u32 s78, s78, 1
s_branch L_dloop
L_pub:
s_cmp_eq_u32 s53, 0
s_cbranch_scc1 L_sgo
v_mov_b32 v166, 2
s_mov_b64 exec, 1
buffer_store_dword v166, off, s[44:47], s51 sc0 sc1
s_mov_b64 exec, -1
s_branch L_sgo
L_trans:
s_cmp_eq_u32 s78, 8
s_cbranch_scc0 L_chk
s_mov_b64 exec, 1
buffer_load_dword v166, off, s[44:47], s51 sc0 sc1
s_mov_b64 exec, -1
s_branch L_sgo
L_chk:
s_waitcnt vmcnt(14)
v_readfirstlane_b32 s54, v166
s_cmp_eq_u32 s54, 2
s_cbranch_scc0 L_slow
L_slow_ret:
v_mov_b32 v168, 1
s_mov_b64 exec, 1
buffer_atomic_add v168, off, s[56:59], s50 sc0 sc1
s_mov_b64 exec, -1
s_branch L_sgo
L_slow:
v_mov_b32 v166, 1
v_mov_b32 v167, 0
s_mov_b64 exec, 1
buffer_atomic_cmpswap v[166:167], off, s[44:47], s51 sc0 sc1
s_waitcnt vmcnt(0)
v_readfirstlane_b32 s54, v166
s_cmp_eq_u32 s54, 2
s_cbranch_scc1 L_slow_done
s_cmp_eq_u32 s54, 0
s_cbranch_scc0 L_slow_spin
v_mov_b32 v166, 0
buffer_atomic_swap v166, off, s[56:59], s50 sc0 sc1
s_waitcnt vmcnt(0)
v_mov_b32 v166, 2
buffer_store_dword v166, off, s[44:47], s51 sc0 sc1
s_waitcnt vmcnt(0)
s_branch L_slow_done
L_slow_spin:
buffer_load_dword v166, off, s[44:47], s51 sc0 sc1
s_waitcnt vmcnt(0)
v_readfirstlane_b32 s54, v166
s_cmp_eq_u32 s54, 2
s_cbranch_scc0 L_slow_spin
L_slow_done:
s_mov_b64 exec, -1
s_branch L_slow_ret
L_fin:
L_end:
s_endpgm
.section .rodata,"a"
.p2align 6
.amdhsa_kernel standalone__depthwise_separable__vision_kernel
  .amdhsa_next_free_vgpr 512
  .amdhsa_next_free_sgpr 96
  .amdhsa_accum_offset 256
  .amdhsa_group_segment_fixed_size 0
  .amdhsa_kernarg_size 48
  .amdhsa_user_sgpr_count 2
  .amdhsa_user_sgpr_kernarg_segment_ptr 1
  .amdhsa_system_sgpr_workgroup_id_x 1
  .amdhsa_float_denorm_mode_32 3
.end_amdhsa_kernel
```
